```python
import torch

def _softmax(x, axis=-1):
    return torch.softmax(x, dim=axis)
def _gelu(x):
    return torch.nn.functional.gelu(x, approximate="tanh")
def _silu(x):
    return torch.nn.functional.silu(x)
def _sigmoid(x):
    return torch.sigmoid(x)
def _layernorm(x, axis=-1, eps=1e-5):
    m = x.mean(dim=axis, keepdim=True)
    v = x.var(dim=axis, keepdim=True, unbiased=False)
    return (x - m) / torch.sqrt(v + eps)
def _scatter_add(tgt, idx, src, axis=0):
    return tgt.clone().index_add_(axis, idx, src)
def _segment_sum(src, seg, n):
    out = torch.zeros((n,) + src.shape[1:], dtype=src.dtype)
    return out.index_add_(0, seg, src)
def _pad(x, pw):
    flat = tuple(v for pair in reversed(pw) for v in pair)
    return torch.nn.functional.pad(x, flat)

kernel_name = 'recurrent_scan__sliding_block_cached__dense_activation_gelu__decode'

def setup_inputs():

    _w = (lambda a: (lambda t: t.to(torch.bfloat16) if t.is_floating_point() else t)(torch.as_tensor(a)))
    def _A_setup():
        B, Sq, D = 1, 1, 640
        Hq, Hkv, Sk, Dh = 32, 32, 4096, 128
        assert Hq % Hkv == 0, (Hq, Hkv)
        return {
            "x": _w((lambda *s: torch.randn(*s, dtype=torch.bfloat16) * 0.05)(B, Sq, D)),
            "k_cache": _w((lambda *s: torch.randn(*s, dtype=torch.bfloat16) * 3.2)(B, Hkv, Sk, Dh)),
            "v_cache": _w((lambda *s: torch.randn(*s, dtype=torch.bfloat16) * 3.2)(B, Hkv, Sk, Dh)),
            "wq": _w((lambda *s: torch.randn(*s, dtype=torch.bfloat16) * 3.2)(D, Hq * Dh) * (D ** -0.5)),
            "wo": _w((lambda *s: torch.randn(*s, dtype=torch.bfloat16) * 3.2)(Hq * Dh, D) * ((Hq * Dh) ** -0.5)),
        }
    _A_in = _A_setup()

    def _B_setup():
        B, S, D, F = 1, 1, 640, 1728
        return {
            "x": _w((lambda *s: torch.randn(*s, dtype=torch.bfloat16) * 0.05)(B, S, D)),
            "w1": _w((lambda *s: torch.randn(*s, dtype=torch.bfloat16) * 3.2)(D, F) * (D ** -0.5)),
            "b1": _w((lambda *s: torch.randn(*s, dtype=torch.bfloat16) * 3.2)(F) * 0.01),
            "w2": _w((lambda *s: torch.randn(*s, dtype=torch.bfloat16) * 0.4)(F, D) * (F ** -0.5)),
            "b2": _w((lambda *s: torch.randn(*s, dtype=torch.bfloat16) * 0.4)(D) * 0.01),
        }
    _B_in = _B_setup()

    return {
        "A_x": _A_in["x"],
        "A_k_cache": _A_in["k_cache"],
        "A_v_cache": _A_in["v_cache"],
        "A_wq": _A_in["wq"],
        "A_wo": _A_in["wo"],
        "B_x": _B_in["x"],
        "B_w1": _B_in["w1"],
        "B_b1": _B_in["b1"],
        "B_w2": _B_in["w2"],
        "B_b2": _B_in["b2"],
    }

def reference(A_x, A_k_cache, A_v_cache, A_wq, A_wo, B_x, B_w1, B_b1, B_w2, B_b2):
    def _A_ref(x, k_cache, v_cache, wq, wo):
        B, Sq, D = x.shape
        Hq, Dh = 32, 128
        Hkv, Sk = k_cache.shape[1], k_cache.shape[2]
        W = min(4096, max(256, Sk // 4))
        rep = Hq // Hkv
        q = (lambda x, *d: x.permute(*d))((x @ wq).reshape(B, Sq, Hq, Dh), 0, 2, 1, 3)
        k = (lambda x, n, axis: torch.repeat_interleave(x, n, dim=axis))(k_cache[:, :, Sk - W:, :], rep, axis=1)
        v = (lambda x, n, axis: torch.repeat_interleave(x, n, dim=axis))(v_cache[:, :, Sk - W:, :], rep, axis=1)
        scores = torch.einsum("bhqd,bhkd->bhqk", q, k) * (Dh ** -0.5)
        p = _softmax(scores, axis=-1)
        o = torch.einsum("bhqk,bhkd->bhqd", p, v)
        return (lambda x, *d: x.permute(*d))(o, 0, 2, 1, 3).reshape(B, Sq, Hq * Dh) @ wo

    def _B_ref(x, w1, b1, w2, b2):
        h = torch.einsum("bsd,df->bsf", x, w1) + b1
        h = _gelu(h)
        return torch.einsum("bsf,fd->bsd", h, w2) + b2

    x = A_x
    xn = _layernorm(x, axis=-1)
    s = _A_ref(xn, A_k_cache, A_v_cache, A_wq, A_wo)
    g = _silu(_B_ref(xn, B_w1, B_b1, B_w2, B_b2))
    return x + s * g
```

```asm
; @launch grid=(256,1,1) block=(576,1,1) lds=31616
.amdgcn_target "amdgcn-amd-amdhsa--gfx950"
.text
.globl recurrent_scan__sliding_block_cached__dense_activation_gelu__decode_kernel
.p2align 8
.type recurrent_scan__sliding_block_cached__dense_activation_gelu__decode_kernel,@function
recurrent_scan__sliding_block_cached__dense_activation_gelu__decode_kernel:
    s_cmp_ge_u32 s2, 256
    s_cbranch_scc1 L_end
    s_load_dwordx16 s[4:19], s[0:1], 0
    s_load_dwordx8 s[20:27], s[0:1], 64
    s_load_dwordx2 s[28:29], s[0:1], 96
    s_mov_b32 s46, 0
    v_lshrrev_b32 v2, 6, v0
    v_and_b32 v1, 63, v0
    v_readfirstlane_b32 s33, v2
    s_lshr_b32 s3, s2, 6
    s_lshl_b32 s3, s3, 3
    s_and_b32 s34, s2, 7
    s_or_b32 s34, s34, s3
    s_bfe_u32 s35, s2, 0x30003
    s_cmp_eq_u32 s33, 8
    s_cbranch_scc1 L_comm
    v_lshlrev_b32 v5, 4, v1
    v_lshlrev_b32 v103, 2, v1
    s_mul_i32 s3, s35, 80
    s_lshl_b32 s68, s33, 4
    s_sub_u32 s69, s33, 5
    s_lshl_b32 s69, s69, 5
    s_lshl_b32 s70, s34, 8
    s_lshl_b32 s71, s34, 7
    s_cmp_ge_u32 s34, 27
    s_cselect_b32 s61, 2, 1
    s_mov_b32 s38, 3456
    s_cmp_lt_u32 s33, 5
    s_cselect_b32 s61, 0, s61
    s_cselect_b32 s68, s68, s69
    s_cselect_b32 s70, s70, s71
    s_cselect_b32 s38, 8192, s38
    s_cselect_b32 s69, 15, 7
    s_cselect_b32 s71, 4, 3
    s_cmp_eq_u32 s33, 7
    s_cselect_b32 s39, 3, 15
    v_lshrrev_b32 v115, s71, v1
    v_min_u32 v104, s39, v115
    v_lshlrev_b32 v104, 2, v104
    v_add_u32 v104, s68, v104
    v_lshlrev_b32 v6, 1, v104
    v_add_u32 v104, s3, v104
    s_lshl_b32 s60, s3, 1
    v_add_u32 v106, s60, v103
    v_min_u32 v106, 0x4fc, v106
    s_cmp_eq_u32 s61, 2
    s_cselect_b32 s38, 0, s38
    s_cselect_b32 s70, 0, s70
    s_cselect_b32 s69, 0, s69
    v_mul_lo_u32 v92, v104, s38
    v_and_b32 v105, s69, v1
    v_lshlrev_b32 v105, 4, v105
    v_add3_u32 v92, v92, v105, s70
    v_add_u32 v93, s38, v92
    v_add_u32 v94, s38, v93
    v_add_u32 v95, s38, v94
    s_waitcnt lgkmcnt(0)
    s_cmp_lg_u32 s33, 0
    s_cbranch_scc1 L_nox
    global_load_dwordx4 v[16:19], v5, s[4:5]
    global_load_dword v20, v103, s[4:5] offset:1024
    global_load_dword v22, v106, s[4:5]
    s_load_dword s63, s[4:5], 0
L_nox:
    s_cmp_eq_u32 s61, 0
    s_cselect_b64 s[36:37], s[10:11], s[16:17]
    s_cmp_eq_u32 s61, 2
    s_cselect_b64 s[36:37], s[4:5], s[36:37]
    s_cmp_lg_u32 s61, 0
    s_cbranch_scc1 L_nowq
    global_load_dwordx4 v[24:27], v92, s[36:37] nt
    global_load_dwordx4 v[28:31], v93, s[36:37] nt
    global_load_dwordx4 v[32:35], v94, s[36:37] nt
    global_load_dwordx4 v[36:39], v95, s[36:37] nt
L_nowq:
    v_lshrrev_b32 v2, 4, v1
    v_and_b32 v3, 15, v1
    v_lshlrev_b32 v99, 4, v3
    v_lshl_add_u32 v96, v2, 10, v99
    s_lshl_b32 s40, s34, 20
    s_lshl_b32 s3, s35, 15
    s_add_u32 s40, s40, s3
    s_lshl_b32 s3, s33, 12
    s_add_u32 s40, s40, s3
    s_add_u32 s40, s40, 786432
    s_add_u32 s42, s8, s40
    s_addc_u32 s43, s9, 0
    s_add_u32 s40, s6, s40
    s_addc_u32 s41, s7, 0
    global_load_dwordx4 v[40:43], v96, s[40:41] offset:0 nt
    global_load_dwordx4 v[44:47], v96, s[40:41] offset:256 nt
    s_cmp_eq_u32 s61, 0
    s_cbranch_scc1 L_now1
    global_load_dwordx4 v[24:27], v92, s[36:37] nt
    global_load_dwordx4 v[28:31], v93, s[36:37] nt
    global_load_dwordx4 v[32:35], v94, s[36:37] nt
    global_load_dwordx4 v[36:39], v95, s[36:37] nt
L_now1:
    s_getpc_b64 s[66:67]
L_pcl:
    v_lshlrev_b32 v102, 4, v0
    v_min_u32 v102, (L_code_end-L_pcl-16), v102
    global_load_dwordx4 v[88:91], v102, s[66:67]
    v_cmp_ge_u32 vcc, s39, v115
    s_nop 1
    v_cndmask_b32 v106, 0, -1, vcc
    s_cmp_eq_u32 s61, 2
    s_cselect_b32 s3, 0, -1
    v_and_b32 v106, s3, v106
    v_and_b32 v107, 3, v1
    v_lshlrev_b32 v107, 4, v107
    v_mov_b32 v108, 0xffff
    v_mov_b32 v109, 0
    v_lshlrev_b64 v[108:109], v107, v[108:109]
    v_and_b32 v110, 4, v1
    v_cmp_eq_u32 vcc, 0, v110
    s_nop 1
    v_cndmask_b32 v8, 0, v108, vcc
    v_cndmask_b32 v9, 0, v109, vcc
    v_cndmask_b32 v10, v108, 0, vcc
    v_cndmask_b32 v11, v109, 0, vcc
    v_and_b32 v12, v8, v106
    v_and_b32 v13, v9, v106
    v_and_b32 v14, v10, v106
    v_and_b32 v15, v11, v106
    v_min_u32 v102, 9, v3
    v_lshlrev_b32 v102, 4, v102
    v_mul_u32_u24 v97, 0x1400, v2
    v_add_u32 v97, v97, v102
    s_mul_i32 s3, s33, 1536
    v_mul_u32_u24 v98, 0x180, v2
    v_add3_u32 v98, v98, v99, s3
    s_lshl_b32 s3, s33, 5
    v_lshlrev_b32 v100, 3, v2
    v_add_u32 v100, s3, v100
    s_mul_i32 s44, s34, 163840
    s_mul_i32 s3, s33, 20480
    s_mul_i32 s45, s35, 160
    s_add_u32 s3, s3, s45
    s_add_u32 s44, s44, s3
    s_min_u32 s60, s34, 26
    s_mul_i32 s60, s60, 81920
    s_add_u32 s60, s60, s3
    s_sub_u32 s60, s60, 81920
    s_add_u32 s44, s12, s44
    s_addc_u32 s45, s13, 0
    s_add_u32 s48, s20, s60
    s_addc_u32 s49, s21, 0
    s_cmp_ge_u32 s33, 4
    s_cselect_b32 s47, 1, 0
    s_cmp_ge_u32 s34, 27
    s_cselect_b32 s47, 0, s47
    s_mov_b32 s56, 0x01000100
    s_mov_b32 s57, 0x03020302
    s_mov_b32 s58, 0xaaaaaaaa
    s_mov_b32 s59, 0xaaaaaaaa
    s_cmp_lg_u32 s33, 0
    s_cbranch_scc1 L_noln
    s_waitcnt lgkmcnt(0)
    s_lshl_b32 s63, s63, 16
    s_waitcnt vmcnt(7)
    v_lshlrev_b32 v102, 16, v16
    v_and_b32 v103, 0xffff0000, v16
    v_lshlrev_b32 v104, 16, v17
    v_and_b32 v105, 0xffff0000, v17
    v_lshlrev_b32 v106, 16, v18
    v_and_b32 v107, 0xffff0000, v18
    v_lshlrev_b32 v108, 16, v19
    v_and_b32 v109, 0xffff0000, v19
    v_lshlrev_b32 v110, 16, v20
    v_and_b32 v111, 0xffff0000, v20
    v_subrev_f32 v102, s63, v102
    v_subrev_f32 v103, s63, v103
    v_subrev_f32 v104, s63, v104
    v_subrev_f32 v105, s63, v105
    v_subrev_f32 v106, s63, v106
    v_subrev_f32 v107, s63, v107
    v_subrev_f32 v108, s63, v108
    v_subrev_f32 v109, s63, v109
    v_subrev_f32 v110, s63, v110
    v_subrev_f32 v111, s63, v111
    v_add_f32 v112, v102, v103
    v_mul_f32 v113, v102, v102
    v_fmac_f32 v113, v103, v103
    v_add_f32 v112, v112, v104
    v_fmac_f32 v113, v104, v104
    v_add_f32 v112, v112, v105
    v_fmac_f32 v113, v105, v105
    v_add_f32 v112, v112, v106
    v_fmac_f32 v113, v106, v106
    v_add_f32 v112, v112, v107
    v_fmac_f32 v113, v107, v107
    v_add_f32 v112, v112, v108
    v_fmac_f32 v113, v108, v108
    v_add_f32 v112, v112, v109
    v_fmac_f32 v113, v109, v109
    v_add_f32 v112, v112, v110
    v_fmac_f32 v113, v110, v110
    v_add_f32 v112, v112, v111
    v_fmac_f32 v113, v111, v111
    s_nop 0
    v_add_f32_dpp v112, v112, v112 quad_perm:[1,0,3,2] row_mask:0xf bank_mask:0xf
    v_add_f32_dpp v113, v113, v113 quad_perm:[1,0,3,2] row_mask:0xf bank_mask:0xf
    s_nop 0
    v_add_f32_dpp v112, v112, v112 quad_perm:[2,3,0,1] row_mask:0xf bank_mask:0xf
    v_add_f32_dpp v113, v113, v113 quad_perm:[2,3,0,1] row_mask:0xf bank_mask:0xf
    s_nop 0
    v_add_f32_dpp v112, v112, v112 row_half_mirror row_mask:0xf bank_mask:0xf
    v_add_f32_dpp v113, v113, v113 row_half_mirror row_mask:0xf bank_mask:0xf
    s_nop 0
    v_add_f32_dpp v112, v112, v112 row_mirror row_mask:0xf bank_mask:0xf
    v_add_f32_dpp v113, v113, v113 row_mirror row_mask:0xf bank_mask:0xf
    s_nop 0
    v_add_f32_dpp v112, v112, v112 row_bcast:15 row_mask:0xa bank_mask:0xf
    v_add_f32_dpp v113, v113, v113 row_bcast:15 row_mask:0xa bank_mask:0xf
    s_nop 0
    v_add_f32_dpp v112, v112, v112 row_bcast:31 row_mask:0xc bank_mask:0xf
    v_add_f32_dpp v113, v113, v113 row_bcast:31 row_mask:0xc bank_mask:0xf
    v_readlane_b32 s68, v112, 63
    v_readlane_b32 s69, v113, 63
    v_lshlrev_b32 v102, 16, v22
    v_and_b32 v103, 0xffff0000, v22
    v_mov_b32 v112, 0x3acccccd
    v_mul_f32 v113, s69, v112
    v_mul_f32 v112, s68, v112
    v_fma_f32 v113, -v112, v112, v113
    v_add_f32 v112, s63, v112
    v_max_f32 v113, 0, v113
    v_cvt_pk_bf16_f32 v114, v112, v113
    v_and_b32 v113, 0xffff0000, v114
    v_lshlrev_b32 v112, 16, v114
    v_add_f32 v113, 0x3727c5ac, v113
    v_sub_f32 v102, v102, v112
    v_sub_f32 v103, v103, v112
    v_cvt_pk_bf16_f32 v113, v113, v113
    v_cvt_pk_bf16_f32 v106, v102, v103
    v_and_b32 v113, 0xffff0000, v113
    v_sqrt_f32 v113, v113
    v_lshlrev_b32 v102, 16, v106
    v_and_b32 v103, 0xffff0000, v106
    v_cvt_pk_bf16_f32 v113, v113, v113
    v_and_b32 v113, 0xffff0000, v113
    v_rcp_f32 v113, v113
    s_nop 0
    v_mul_f32 v102, v102, v113
    v_mul_f32 v103, v103, v113
    v_cvt_pk_bf16_f32 v106, v102, v103
    v_lshlrev_b32 v107, 2, v1
    s_mov_b32 s68, -1
    s_mov_b32 s69, 0xff
    s_mov_b64 exec, s[68:69]
    ds_write_b32 v107, v106 offset:31424
    s_mov_b64 exec, -1
    s_waitcnt lgkmcnt(0)
L_noln:
    s_barrier
    s_mov_b32 s62, 0xcccccccc
    s_mov_b32 s63, 0xcccccccc
    ds_read_b64 v[102:103], v6 offset:31424
    s_waitcnt lgkmcnt(0)
    v_perm_b32 v110, v102, v102, s56
    v_perm_b32 v111, v102, v102, s57
    v_perm_b32 v112, v103, v103, s56
    v_perm_b32 v113, v103, v103, s57
    v_and_b32 v144, v12, v110
    v_and_b32 v145, v13, v110
    v_and_b32 v146, v14, v110
    v_and_b32 v147, v15, v110
    v_and_b32 v148, v12, v111
    v_and_b32 v149, v13, v111
    v_and_b32 v150, v14, v111
    v_and_b32 v151, v15, v111
    v_and_b32 v152, v12, v112
    v_and_b32 v153, v13, v112
    v_and_b32 v154, v14, v112
    v_and_b32 v155, v15, v112
    v_and_b32 v156, v12, v113
    v_and_b32 v157, v13, v113
    v_and_b32 v158, v14, v113
    v_and_b32 v159, v15, v113
    s_cmp_lg_u32 s61, 0
    s_cbranch_scc1 L_b1
    s_waitcnt vmcnt(3)
    v_mfma_f32_16x16x32_bf16 v[72:75], v[144:147], v[24:27], 0
    v_mfma_f32_16x16x32_bf16 v[72:75], v[148:151], v[28:31], v[72:75]
    v_mfma_f32_16x16x32_bf16 v[72:75], v[152:155], v[32:35], v[72:75]
    v_mfma_f32_16x16x32_bf16 v[72:75], v[156:159], v[36:39], v[72:75]
    s_nop 7
    ds_write_b128 v98, v[72:75] offset:0
    s_waitcnt lgkmcnt(0)
L_b1:
    s_barrier
    s_barrier
    global_load_dwordx4 v[48:51], v96, s[40:41] offset:512 nt
    global_load_dwordx4 v[52:55], v96, s[40:41] offset:768 nt
    global_load_dwordx4 v[56:59], v96, s[42:43] offset:0 nt
    s_cmp_eq_u32 s61, 0
    s_cbranch_scc1 L_b15
    s_waitcnt vmcnt(4)
    v_mfma_f32_16x16x32_bf16 v[72:75], v[144:147], v[24:27], 0
    v_mfma_f32_16x16x32_bf16 v[72:75], v[148:151], v[28:31], v[72:75]
    v_mfma_f32_16x16x32_bf16 v[72:75], v[152:155], v[32:35], v[72:75]
    v_mfma_f32_16x16x32_bf16 v[72:75], v[156:159], v[36:39], v[72:75]
    s_nop 7
    ds_write_b128 v98, v[72:75] offset:0
    s_waitcnt lgkmcnt(0)
L_b15:
    s_barrier
    global_load_dwordx4 v[60:63], v96, s[42:43] offset:256 nt
    global_load_dwordx4 v[64:67], v96, s[42:43] offset:512 nt
    global_load_dwordx4 v[68:71], v96, s[42:43] offset:768 nt
    global_load_dwordx4 v[24:27], v97, s[44:45] offset:0 nt
    global_load_dwordx4 v[28:31], v97, s[44:45] offset:1280 nt
    s_cmp_eq_u32 s47, 0
    s_cbranch_scc1 L_now2e
    global_load_dwordx4 v[128:131], v97, s[48:49] offset:0 nt
    global_load_dwordx4 v[132:135], v97, s[48:49] offset:1280 nt
    global_load_dwordx4 v[136:139], v97, s[48:49] offset:2560 nt
    global_load_dwordx4 v[140:143], v97, s[48:49] offset:3840 nt
L_now2e:
    s_barrier
    ds_read_b128 v[84:87], v99 offset:30720
    s_mov_b32 s3, 0x3db504f3
    s_mov_b32 s60, 0x3fb8aa3b
    s_cmp_eq_u32 s47, 0
    s_cbranch_scc1 L_wka
    s_waitcnt vmcnt(10) lgkmcnt(0)
    s_branch L_wkb
L_wka:
    s_waitcnt vmcnt(6) lgkmcnt(0)
L_wkb:
    v_dot2_f32_bf16 v72, v40, v84, 0
    v_dot2_f32_bf16 v73, v44, v84, 0
    v_dot2_f32_bf16 v74, v48, v84, 0
    v_dot2_f32_bf16 v75, v52, v84, 0
    v_dot2_f32_bf16 v72, v41, v85, v72
    v_dot2_f32_bf16 v73, v45, v85, v73
    v_dot2_f32_bf16 v74, v49, v85, v74
    v_dot2_f32_bf16 v75, v53, v85, v75
    v_dot2_f32_bf16 v72, v42, v86, v72
    v_dot2_f32_bf16 v73, v46, v86, v73
    v_dot2_f32_bf16 v74, v50, v86, v74
    v_dot2_f32_bf16 v75, v54, v86, v75
    v_dot2_f32_bf16 v72, v43, v87, v72
    v_dot2_f32_bf16 v73, v47, v87, v73
    v_dot2_f32_bf16 v74, v51, v87, v74
    v_dot2_f32_bf16 v75, v55, v87, v75
    s_nop 1
    v_cndmask_b32 v102, v72, v74, s[58:59]
    v_cndmask_b32 v103, v74, v72, s[58:59]
    v_cndmask_b32 v104, v73, v75, s[58:59]
    v_cndmask_b32 v105, v75, v73, s[58:59]
    v_add_f32_dpp v102, v103, v102 quad_perm:[1,0,3,2] row_mask:0xf bank_mask:0xf
    s_nop 0
    v_add_f32_dpp v104, v105, v104 quad_perm:[1,0,3,2] row_mask:0xf bank_mask:0xf
    v_cndmask_b32 v106, v102, v104, s[62:63]
    v_cndmask_b32 v107, v104, v102, s[62:63]
    s_nop 1
    v_add_f32_dpp v106, v107, v106 quad_perm:[2,3,0,1] row_mask:0xf bank_mask:0xf
    s_nop 1
    v_add_f32_dpp v106, v106, v106 row_ror:4 row_mask:0xf bank_mask:0xf
    s_nop 1
    v_add_f32_dpp v106, v106, v106 row_ror:8 row_mask:0xf bank_mask:0xf
    v_cvt_pk_bf16_f32 v106, v106, v106
    v_and_b32 v106, 0xffff0000, v106
    v_mul_f32 v106, s3, v106
    v_cvt_pk_bf16_f32 v106, v106, v106
    v_and_b32 v106, 0xffff0000, v106
    s_nop 1
    v_max_f32_dpp v108, v106, v106 quad_perm:[1,0,3,2] row_mask:0xf bank_mask:0xf
    s_nop 1
    v_max_f32_dpp v108, v108, v108 quad_perm:[2,3,0,1] row_mask:0xf bank_mask:0xf
    s_nop 1
    v_max_f32_dpp v108, v108, v108 row_bcast:15 row_mask:0xa bank_mask:0xf
    s_nop 1
    v_max_f32_dpp v108, v108, v108 row_bcast:31 row_mask:0xc bank_mask:0xf
    s_nop 0
    v_readlane_b32 s64, v108, 63
    s_nop 1
    v_subrev_f32 v106, s64, v106
    v_mul_f32 v106, s60, v106
    v_exp_f32 v106, v106
    s_nop 0
    v_cvt_pk_bf16_f32 v110, v106, v106
    s_nop 1
    v_and_b32_dpp v144, v110, v8 quad_perm:[0,0,0,0] row_mask:0xf bank_mask:0xf
    v_and_b32_dpp v145, v110, v9 quad_perm:[0,0,0,0] row_mask:0xf bank_mask:0xf
    v_and_b32_dpp v146, v110, v10 quad_perm:[0,0,0,0] row_mask:0xf bank_mask:0xf
    v_and_b32_dpp v147, v110, v11 quad_perm:[0,0,0,0] row_mask:0xf bank_mask:0xf
    v_and_b32_dpp v148, v110, v8 quad_perm:[2,2,2,2] row_mask:0xf bank_mask:0xf
    v_and_b32_dpp v149, v110, v9 quad_perm:[2,2,2,2] row_mask:0xf bank_mask:0xf
    v_and_b32_dpp v150, v110, v10 quad_perm:[2,2,2,2] row_mask:0xf bank_mask:0xf
    v_and_b32_dpp v151, v110, v11 quad_perm:[2,2,2,2] row_mask:0xf bank_mask:0xf
    v_and_b32_dpp v152, v110, v8 quad_perm:[1,1,1,1] row_mask:0xf bank_mask:0xf
    v_and_b32_dpp v153, v110, v9 quad_perm:[1,1,1,1] row_mask:0xf bank_mask:0xf
    v_and_b32_dpp v154, v110, v10 quad_perm:[1,1,1,1] row_mask:0xf bank_mask:0xf
    v_and_b32_dpp v155, v110, v11 quad_perm:[1,1,1,1] row_mask:0xf bank_mask:0xf
    v_and_b32_dpp v156, v110, v8 quad_perm:[3,3,3,3] row_mask:0xf bank_mask:0xf
    v_and_b32_dpp v157, v110, v9 quad_perm:[3,3,3,3] row_mask:0xf bank_mask:0xf
    v_and_b32_dpp v158, v110, v10 quad_perm:[3,3,3,3] row_mask:0xf bank_mask:0xf
    v_and_b32_dpp v159, v110, v11 quad_perm:[3,3,3,3] row_mask:0xf bank_mask:0xf
    v_add_f32_dpp v109, v106, v106 quad_perm:[1,0,3,2] row_mask:0xf bank_mask:0xf
    s_nop 1
    v_add_f32_dpp v109, v109, v109 quad_perm:[2,3,0,1] row_mask:0xf bank_mask:0xf
    s_nop 1
    v_add_f32_dpp v109, v109, v109 row_bcast:15 row_mask:0xa bank_mask:0xf
    s_nop 1
    v_add_f32_dpp v109, v109, v109 row_bcast:31 row_mask:0xc bank_mask:0xf
    s_lshl_b32 s3, s33, 3
    v_mov_b32 v114, s3
    s_mov_b32 s68, 0
    s_mov_b32 s69, 0x80000000
    s_mov_b64 exec, s[68:69]
    ds_write_b64 v114, v[108:109] offset:31360
    s_mov_b64 exec, -1
    s_cmp_eq_u32 s47, 0
    s_cbranch_scc1 L_wva
    s_waitcnt vmcnt(6)
    s_branch L_wvb
L_wva:
    s_waitcnt vmcnt(2)
L_wvb:
    v_mfma_f32_16x16x32_bf16 v[72:75], v[144:147], v[56:59], 0
    v_mfma_f32_16x16x32_bf16 v[72:75], v[148:151], v[60:63], v[72:75]
    v_mfma_f32_16x16x32_bf16 v[72:75], v[152:155], v[64:67], v[72:75]
    v_mfma_f32_16x16x32_bf16 v[72:75], v[156:159], v[68:71], v[72:75]
    s_nop 7
    ds_write_b128 v98, v[72:75] offset:12288
    s_waitcnt lgkmcnt(0)
    s_barrier
    s_barrier
    s_cmp_eq_u32 s47, 0
    s_cbranch_scc0 L_ffn
    global_load_dwordx4 v[32:35], v97, s[44:45] offset:2560 nt
    global_load_dwordx4 v[36:39], v97, s[44:45] offset:3840 nt
    s_barrier
    s_branch L_noffn
L_ffn:
    global_load_dwordx4 v[32:35], v97, s[44:45] offset:2560 nt
    global_load_dwordx4 v[36:39], v97, s[44:45] offset:3840 nt
    s_barrier
    ds_read_b64 v[102:103], v100 offset:30848
    s_waitcnt vmcnt(2) lgkmcnt(0)
    v_perm_b32 v110, v102, v102, s56
    v_perm_b32 v111, v102, v102, s57
    v_perm_b32 v112, v103, v103, s56
    v_perm_b32 v113, v103, v103, s57
    v_and_b32 v76, v8, v110
    v_and_b32 v77, v9, v110
    v_and_b32 v78, v10, v110
    v_and_b32 v79, v11, v110
    s_nop 1
    v_mfma_f32_16x16x32_bf16 v[72:75], v[76:79], v[128:131], 0
    v_and_b32 v80, v8, v111
    v_and_b32 v81, v9, v111
    v_and_b32 v82, v10, v111
    v_and_b32 v83, v11, v111
    s_nop 1
    v_mfma_f32_16x16x32_bf16 v[72:75], v[80:83], v[132:135], v[72:75]
    v_and_b32 v76, v8, v112
    v_and_b32 v77, v9, v112
    v_and_b32 v78, v10, v112
    v_and_b32 v79, v11, v112
    s_nop 1
    v_mfma_f32_16x16x32_bf16 v[72:75], v[76:79], v[136:139], v[72:75]
    v_and_b32 v80, v8, v113
    v_and_b32 v81, v9, v113
    v_and_b32 v82, v10, v113
    v_and_b32 v83, v11, v113
    s_nop 1
    v_mfma_f32_16x16x32_bf16 v[72:75], v[80:83], v[140:143], v[72:75]
    s_nop 7
    ds_write_b128 v98, v[72:75] offset:18432
    s_waitcnt lgkmcnt(0)
L_noffn:
    s_barrier
    ds_read_b64 v[102:103], v100 offset:31104
    s_waitcnt vmcnt(0) lgkmcnt(0)
    v_perm_b32 v110, v102, v102, s56
    v_perm_b32 v111, v102, v102, s57
    v_perm_b32 v112, v103, v103, s56
    v_perm_b32 v113, v103, v103, s57
    v_and_b32 v76, v8, v110
    v_and_b32 v77, v9, v110
    v_and_b32 v78, v10, v110
    v_and_b32 v79, v11, v110
    s_nop 1
    v_mfma_f32_16x16x32_bf16 v[72:75], v[76:79], v[24:27], 0
    v_and_b32 v80, v8, v111
    v_and_b32 v81, v9, v111
    v_and_b32 v82, v10, v111
    v_and_b32 v83, v11, v111
    s_nop 1
    v_mfma_f32_16x16x32_bf16 v[72:75], v[80:83], v[28:31], v[72:75]
    v_and_b32 v76, v8, v112
    v_and_b32 v77, v9, v112
    v_and_b32 v78, v10, v112
    v_and_b32 v79, v11, v112
    s_nop 1
    v_mfma_f32_16x16x32_bf16 v[72:75], v[76:79], v[32:35], v[72:75]
    v_and_b32 v80, v8, v113
    v_and_b32 v81, v9, v113
    v_and_b32 v82, v10, v113
    v_and_b32 v83, v11, v113
    s_nop 1
    v_mfma_f32_16x16x32_bf16 v[72:75], v[80:83], v[36:39], v[72:75]
    s_nop 7
    ds_write_b128 v98, v[72:75] offset:0
    s_waitcnt lgkmcnt(0)
    s_barrier
    s_branch L_fin_stamps
L_comm:
    v_lshlrev_b32 v2, 4, v1
    v_lshlrev_b32 v4, 2, v1
    v_lshrrev_b32 v108, 2, v1
    v_lshlrev_b32 v3, 4, v108
    v_bfe_u32 v109, v1, 1, 1
    v_mul_u32_u24 v109, 0x180, v109
    v_and_b32 v110, 1, v1
    v_lshlrev_b32 v110, 3, v110
    v_add3_u32 v3, v3, v109, v110
    v_and_b32 v108, 7, v1
    v_lshlrev_b32 v5, 11, v108
    v_lshrrev_b32 v109, 1, v1
    v_lshlrev_b32 v6, 11, v109
    v_lshl_add_u32 v6, v110, 6, v6
    s_lshl_b32 s3, s34, 14
    s_add_u32 s38, s3, 4096
    s_lshl_b32 s39, s35, 11
    s_mul_i32 s60, s35, 40960
    s_add_u32 s60, s60, 2101248
    s_mul_i32 s62, s35, 160
    s_lshl_b32 s3, s34, 3
    s_add_u32 s62, s62, s3
    s_min_u32 s62, s62, 1272
    s_min_u32 s61, s34, 26
    s_lshl_b32 s61, s61, 7
    v_and_b32 v111, 31, v1
    v_lshlrev_b32 v111, 2, v111
    v_add_u32 v111, s61, v111
    s_waitcnt lgkmcnt(0)
    s_load_dword s30, s[28:29], 0
    s_load_dwordx2 s[40:41], s[4:5], s62
    s_load_dwordx2 s[42:43], s[22:23], s62
    s_add_u32 s52, s28, s38
    s_addc_u32 s53, s29, 0
    s_add_u32 s54, s52, s39
    s_addc_u32 s55, s53, 0
    s_add_u32 s36, s52, 524288
    s_addc_u32 s37, s53, 0
    s_add_u32 s44, s54, 524288
    s_addc_u32 s45, s55, 0
    s_add_u32 s58, s28, s60
    s_addc_u32 s59, s29, 0
    s_lshl_b32 s3, s34, 4
    s_add_u32 s56, s58, s3
    s_addc_u32 s57, s59, 0
    s_lshl_b32 s3, s34, 11
    s_add_u32 s58, s58, s3
    s_addc_u32 s59, s59, 0
    s_mul_i32 s3, s34, 2048
    s_add_u32 s3, s3, 2428928
    s_add_u32 s48, s28, s3
    s_addc_u32 s49, s29, 0
    s_lshl_b32 s3, s35, 2
    v_lshlrev_b32 v7, 6, v1
    v_add_u32 v7, s3, v7
    global_load_dwordx4 v[48:51], v2, s[54:55]
    global_load_dwordx4 v[52:55], v2, s[54:55] offset:1024
    global_load_dwordx4 v[56:59], v2, s[44:45]
    global_load_dwordx4 v[60:63], v2, s[44:45] offset:1024
    global_load_dwordx4 v[64:67], v2, s[48:49]
    global_load_dwordx4 v[68:71], v2, s[48:49] offset:1024
    global_load_dword v8, v111, s[18:19]
    s_waitcnt lgkmcnt(0)
    v_mov_b32 v119, 0
    s_mul_i32 s31, s30, 1664525
    s_add_u32 s31, s31, 1013904223
    s_mul_i32 s32, s31, 0x2545f491
    s_add_u32 s32, s32, 0x01234567
    v_mov_b32 v102, s31
    v_mov_b32 v106, s31
    v_mov_b32 v130, s31
    v_mov_b32 v134, s31
    v_mov_b32 v138, s31
    v_mov_b32 v142, s31
    v_mov_b32 v119, s31
    s_barrier
    s_setprio 3
    s_barrier
    ds_read_b64 v[84:85], v3 offset:0
    ds_read_b64 v[86:87], v3 offset:1536
    ds_read_b64 v[88:89], v3 offset:3072
    ds_read_b64 v[90:91], v3 offset:4608
    ds_read_b64 v[92:93], v3 offset:6144
    s_waitcnt lgkmcnt(3)
    v_add_f32 v128, v84, v86
    v_add_f32 v129, v85, v87
    s_waitcnt lgkmcnt(1)
    v_add_f32 v108, v88, v90
    v_add_f32 v109, v89, v91
    v_add_f32 v128, v128, v108
    v_add_f32 v129, v129, v109
    s_waitcnt lgkmcnt(0)
    v_add_f32 v128, v128, v92
    v_add_f32 v129, v129, v93
    v_bitop3_b32 v131, v128, v129, s32 bitop3:0x96
    global_store_dwordx4 v2, v[128:131], s[54:55]
    s_mov_b64 exec, 0xffff
    global_store_dword v7, v119, s[48:49]
    s_mov_b64 exec, -1
    s_barrier
    s_mov_b32 s50, 0
    s_mov_b32 s3, 0
L_p1:
    s_load_dwordx8 s[4:11], s[48:49], s3
    s_add_u32 s3, s3, 64
    s_waitcnt lgkmcnt(0)
    s_xor_b32 s4, s4, s31
    s_xor_b32 s5, s5, s31
    s_xor_b32 s6, s6, s31
    s_xor_b32 s7, s7, s31
    s_xor_b32 s8, s8, s31
    s_xor_b32 s9, s9, s31
    s_xor_b32 s10, s10, s31
    s_xor_b32 s11, s11, s31
    s_or_b32 s4, s4, s5
    s_or_b32 s6, s6, s7
    s_or_b32 s8, s8, s9
    s_or_b32 s10, s10, s11
    s_or_b32 s4, s4, s6
    s_or_b32 s8, s8, s10
    s_or_b32 s4, s4, s8
    s_cbranch_scc1 L_p1_retry
L_p1_ok:
    v_add_u32 v122, 0x1000, v2
    v_add_u32 v123, 0x2000, v2
    v_add_u32 v121, 0x3000, v2
    global_load_dwordx4 v[16:19], v2, s[52:53] offset:0 sc1
    global_load_dwordx4 v[20:23], v2, s[52:53] offset:2048 sc1
    global_load_dwordx4 v[24:27], v122, s[52:53] offset:0 sc1
    global_load_dwordx4 v[28:31], v122, s[52:53] offset:2048 sc1
    global_load_dwordx4 v[32:35], v123, s[52:53] offset:0 sc1
    global_load_dwordx4 v[36:39], v123, s[52:53] offset:2048 sc1
    global_load_dwordx4 v[40:43], v121, s[52:53] offset:0 sc1
    global_load_dwordx4 v[44:47], v121, s[52:53] offset:2048 sc1
    s_barrier
    ds_read_b64 v[84:85], v3 offset:7680
    ds_read_b64 v[86:87], v3 offset:8576
    ds_read_b64 v[88:89], v3 offset:9216
    ds_read_b64 v[90:91], v3 offset:10112
    ds_read_b64 v[92:93], v3 offset:10752
    ds_read_b64 v[94:95], v3 offset:11648
    s_waitcnt lgkmcnt(0)
    v_add_f32 v132, v84, v86
    v_add_f32 v133, v85, v87
    v_add_f32 v132, v132, v88
    v_add_f32 v133, v133, v89
    v_add_f32 v132, v132, v90
    v_add_f32 v133, v133, v91
    v_add_f32 v132, v132, v92
    v_add_f32 v133, v133, v93
    v_add_f32 v132, v132, v94
    v_add_f32 v133, v133, v95
    v_bitop3_b32 v135, v132, v133, s32 bitop3:0x96
    s_mov_b64 exec, 0xffffffff
    global_store_dwordx4 v2, v[132:135], s[54:55] offset:1024
    s_mov_b64 exec, -1
    s_cmp_eq_u32 s50, 0
    s_cbranch_scc1 L_hb
    s_add_u32 s68, s54, 1048576
    s_addc_u32 s69, s55, 0
    s_mov_b64 exec, 0xffffffff
    global_store_dwordx4 v2, v[132:135], s[68:69] offset:1024 sc1
    s_mov_b64 exec, -1
L_hb:
    s_waitcnt vmcnt(1)
    v_bitop3_b32 v109, v16, v17, v19 bitop3:0x96
    v_xor_b32 v108, s32, v109
    v_bitop3_b32 v108, v18, s31, v108 bitop3:0xbe
    v_bitop3_b32 v109, v20, v21, v23 bitop3:0x96
    v_bitop3_b32 v108, v109, s32, v108 bitop3:0xbe
    v_bitop3_b32 v108, v22, s31, v108 bitop3:0xbe
    v_bitop3_b32 v109, v24, v25, v27 bitop3:0x96
    v_bitop3_b32 v108, v109, s32, v108 bitop3:0xbe
    v_bitop3_b32 v108, v26, s31, v108 bitop3:0xbe
    v_bitop3_b32 v109, v28, v29, v31 bitop3:0x96
    v_bitop3_b32 v108, v109, s32, v108 bitop3:0xbe
    v_bitop3_b32 v108, v30, s31, v108 bitop3:0xbe
    v_bitop3_b32 v109, v32, v33, v35 bitop3:0x96
    v_bitop3_b32 v108, v109, s32, v108 bitop3:0xbe
    v_bitop3_b32 v108, v34, s31, v108 bitop3:0xbe
    v_bitop3_b32 v109, v36, v37, v39 bitop3:0x96
    v_bitop3_b32 v108, v109, s32, v108 bitop3:0xbe
    v_bitop3_b32 v108, v38, s31, v108 bitop3:0xbe
    v_bitop3_b32 v109, v40, v41, v43 bitop3:0x96
    v_bitop3_b32 v108, v109, s32, v108 bitop3:0xbe
    v_bitop3_b32 v108, v42, s31, v108 bitop3:0xbe
    v_bitop3_b32 v109, v44, v45, v47 bitop3:0x96
    v_bitop3_b32 v108, v109, s32, v108 bitop3:0xbe
    v_bitop3_b32 v108, v46, s31, v108 bitop3:0xbe
    v_cmp_ne_u32 vcc, 0, v108
    s_cbranch_vccnz L_g1_retry
L_g1_ok:
    v_add_f32 v110, v16, v20
    v_add_f32 v111, v17, v21
    v_add_f32 v112, v24, v28
    v_add_f32 v113, v25, v29
    v_add_f32 v110, v110, v112
    v_add_f32 v111, v111, v113
    v_add_f32 v112, v32, v36
    v_add_f32 v113, v33, v37
    v_add_f32 v110, v110, v112
    v_add_f32 v111, v111, v113
    v_add_f32 v112, v40, v44
    v_add_f32 v113, v41, v45
    v_add_f32 v110, v110, v112
    v_add_f32 v111, v111, v113
    v_cvt_pk_bf16_f32 v110, v110, v111
    ds_write_b32 v4, v110 offset:30720
    s_waitcnt lgkmcnt(0)
    s_barrier
    s_cmp_lg_u32 s50, 0
    s_cbranch_scc1 L_b1done
    s_add_u32 s68, s54, 1048576
    s_addc_u32 s69, s55, 0
    global_store_dwordx4 v2, v[128:131], s[68:69] sc1
    s_add_u32 s68, s54, 1048576
    s_addc_u32 s69, s55, 0
    s_mov_b64 exec, 0xffffffff
    global_store_dwordx4 v2, v[132:135], s[68:69] offset:1024 sc1
    s_mov_b64 exec, -1
L_b1done:
    v_and_b32 v120, 7, v1
    v_lshlrev_b32 v120, 3, v120
    s_waitcnt lgkmcnt(0)
    s_barrier
    ds_read_b64 v[108:109], v120 offset:31360
    ds_read_b64 v[84:85], v3 offset:12288
    ds_read_b64 v[86:87], v3 offset:13824
    ds_read_b64 v[88:89], v3 offset:15360
    ds_read_b64 v[90:91], v3 offset:16896
    ds_read_b64 v[92:93], v3 offset:18432
    ds_read_b64 v[94:95], v3 offset:19968
    ds_read_b64 v[96:97], v3 offset:21504
    ds_read_b64 v[98:99], v3 offset:23040
    s_waitcnt lgkmcnt(8)
    v_max_f32_dpp v110, v108, v108 quad_perm:[1,0,3,2] row_mask:0xf bank_mask:0xf
    s_nop 1
    v_max_f32_dpp v110, v110, v110 quad_perm:[2,3,0,1] row_mask:0xf bank_mask:0xf
    s_nop 1
    v_max_f32_dpp v110, v110, v110 row_half_mirror row_mask:0xf bank_mask:0xf
    v_sub_f32 v111, v108, v110
    v_mul_f32 v111, 0x3fb8aa3b, v111
    v_exp_f32 v111, v111
    s_nop 0
    v_mul_f32 v109, v109, v111
    v_readlane_b32 s4, v111, 0
    v_readlane_b32 s5, v111, 1
    v_readlane_b32 s6, v111, 2
    v_readlane_b32 s7, v111, 3
    v_readlane_b32 s8, v111, 4
    v_readlane_b32 s9, v111, 5
    v_readlane_b32 s10, v111, 6
    v_readlane_b32 s11, v111, 7
    v_add_f32_dpp v109, v109, v109 quad_perm:[1,0,3,2] row_mask:0xf bank_mask:0xf
    s_nop 1
    v_add_f32_dpp v109, v109, v109 quad_perm:[2,3,0,1] row_mask:0xf bank_mask:0xf
    s_nop 1
    v_add_f32_dpp v109, v109, v109 row_half_mirror row_mask:0xf bank_mask:0xf
    s_waitcnt lgkmcnt(0)
    v_mul_f32 v136, s4, v84
    v_mul_f32 v137, s4, v85
    v_fmac_f32 v136, s5, v86
    v_fmac_f32 v137, s5, v87
    v_fmac_f32 v136, s6, v88
    v_fmac_f32 v137, s6, v89
    v_fmac_f32 v136, s7, v90
    v_fmac_f32 v137, s7, v91
    v_fmac_f32 v136, s8, v92
    v_fmac_f32 v137, s8, v93
    v_fmac_f32 v136, s9, v94
    v_fmac_f32 v137, s9, v95
    v_fmac_f32 v136, s10, v96
    v_fmac_f32 v137, s10, v97
    v_fmac_f32 v136, s11, v98
    v_fmac_f32 v137, s11, v99
    v_bitop3_b32 v139, v136, v137, s32 bitop3:0x96
    global_store_dwordx4 v2, v[136:139], s[44:45]
    v_mov_b32 v140, v110
    v_mov_b32 v141, v109
    v_bitop3_b32 v143, v140, v141, s32 bitop3:0x96
    s_mov_b64 exec, 1
    global_store_dwordx4 v2, v[140:143], s[44:45] offset:1024
    s_mov_b64 exec, 0xffff
    global_store_dword v7, v119, s[48:49] offset:1024
    s_mov_b64 exec, -1
    s_mov_b64 exec, 0xffffffff
    global_load_dwordx4 v[48:51], v2, s[52:53] offset:1024 sc1
    global_load_dwordx4 v[52:55], v2, s[52:53] offset:3072 sc1
    global_load_dwordx4 v[56:59], v122, s[52:53] offset:1024 sc1
    global_load_dwordx4 v[60:63], v122, s[52:53] offset:3072 sc1
    global_load_dwordx4 v[64:67], v123, s[52:53] offset:1024 sc1
    global_load_dwordx4 v[68:71], v123, s[52:53] offset:3072 sc1
    global_load_dwordx4 v[72:75], v121, s[52:53] offset:1024 sc1
    global_load_dwordx4 v[76:79], v121, s[52:53] offset:3072 sc1
    s_mov_b64 exec, -1
    s_barrier
    s_mov_b32 s51, 0
    s_mov_b32 s3, 1024
L_p2:
    s_load_dwordx8 s[4:11], s[48:49], s3
    s_add_u32 s3, s3, 64
    s_waitcnt lgkmcnt(0)
    s_xor_b32 s4, s4, s31
    s_xor_b32 s5, s5, s31
    s_xor_b32 s6, s6, s31
    s_xor_b32 s7, s7, s31
    s_xor_b32 s8, s8, s31
    s_xor_b32 s9, s9, s31
    s_xor_b32 s10, s10, s31
    s_xor_b32 s11, s11, s31
    s_or_b32 s4, s4, s5
    s_or_b32 s6, s6, s7
    s_or_b32 s8, s8, s9
    s_or_b32 s10, s10, s11
    s_or_b32 s4, s4, s6
    s_or_b32 s8, s8, s10
    s_or_b32 s4, s4, s8
    s_cbranch_scc1 L_p2_retry
L_p2_ok:
    global_load_dwordx4 v[80:83], v5, s[36:37] offset:1024 sc1
    global_load_dwordx4 v[16:19], v2, s[36:37] offset:0 sc1
    global_load_dwordx4 v[20:23], v2, s[36:37] offset:2048 sc1
    global_load_dwordx4 v[24:27], v122, s[36:37] offset:0 sc1
    global_load_dwordx4 v[28:31], v122, s[36:37] offset:2048 sc1
    global_load_dwordx4 v[32:35], v123, s[36:37] offset:0 sc1
    global_load_dwordx4 v[36:39], v123, s[36:37] offset:2048 sc1
    global_load_dwordx4 v[40:43], v121, s[36:37] offset:0 sc1
    global_load_dwordx4 v[44:47], v121, s[36:37] offset:2048 sc1
    s_waitcnt vmcnt(9)
    s_mov_b64 exec, 0xffffffff
    v_bitop3_b32 v109, v48, v49, v51 bitop3:0x96
    v_xor_b32 v108, s32, v109
    v_bitop3_b32 v108, v50, s31, v108 bitop3:0xbe
    v_bitop3_b32 v109, v52, v53, v55 bitop3:0x96
    v_bitop3_b32 v108, v109, s32, v108 bitop3:0xbe
    v_bitop3_b32 v108, v54, s31, v108 bitop3:0xbe
    v_bitop3_b32 v109, v56, v57, v59 bitop3:0x96
    v_bitop3_b32 v108, v109, s32, v108 bitop3:0xbe
    v_bitop3_b32 v108, v58, s31, v108 bitop3:0xbe
    v_bitop3_b32 v109, v60, v61, v63 bitop3:0x96
    v_bitop3_b32 v108, v109, s32, v108 bitop3:0xbe
    v_bitop3_b32 v108, v62, s31, v108 bitop3:0xbe
    v_bitop3_b32 v109, v64, v65, v67 bitop3:0x96
    v_bitop3_b32 v108, v109, s32, v108 bitop3:0xbe
    v_bitop3_b32 v108, v66, s31, v108 bitop3:0xbe
    v_bitop3_b32 v109, v68, v69, v71 bitop3:0x96
    v_bitop3_b32 v108, v109, s32, v108 bitop3:0xbe
    v_bitop3_b32 v108, v70, s31, v108 bitop3:0xbe
    v_bitop3_b32 v109, v72, v73, v75 bitop3:0x96
    v_bitop3_b32 v108, v109, s32, v108 bitop3:0xbe
    v_bitop3_b32 v108, v74, s31, v108 bitop3:0xbe
    v_bitop3_b32 v109, v76, v77, v79 bitop3:0x96
    v_bitop3_b32 v108, v109, s32, v108 bitop3:0xbe
    v_bitop3_b32 v108, v78, s31, v108 bitop3:0xbe
    v_cmp_ne_u32 vcc, 0, v108
    s_cbranch_vccnz L_gh_retry
L_gh_ok:
    v_add_f32 v110, v48, v52
    v_add_f32 v111, v49, v53
    v_add_f32 v112, v56, v60
    v_add_f32 v113, v57, v61
    v_add_f32 v110, v110, v112
    v_add_f32 v111, v111, v113
    v_add_f32 v112, v64, v68
    v_add_f32 v113, v65, v69
    v_add_f32 v110, v110, v112
    v_add_f32 v111, v111, v113
    v_add_f32 v112, v72, v76
    v_add_f32 v113, v73, v77
    v_add_f32 v110, v110, v112
    v_add_f32 v111, v111, v113
    v_cvt_pk_bf16_f32 v108, v110, v111
    v_lshlrev_b32 v109, 16, v108
    v_and_b32 v110, 0xffff0000, v108
    v_lshlrev_b32 v111, 16, v8
    v_and_b32 v112, 0xffff0000, v8
    v_add_f32 v109, v109, v111
    v_add_f32 v110, v110, v112
    v_cvt_pk_bf16_f32 v108, v109, v110
    v_lshlrev_b32 v109, 16, v108
    v_and_b32 v110, 0xffff0000, v108
    s_mov_b32 s3, 0x3d372713
    s_mov_b32 s60, 0xc0135761
    v_mul_f32 v111, v109, v109
    v_mul_f32 v112, v110, v110
    v_mul_f32 v111, v111, v109
    v_mul_f32 v112, v112, v110
    v_fma_f32 v111, v111, s3, v109
    v_fma_f32 v112, v112, s3, v110
    v_mul_f32 v111, s60, v111
    v_mul_f32 v112, s60, v112
    v_exp_f32 v111, v111
    v_exp_f32 v112, v112
    v_add_f32 v111, 1.0, v111
    v_add_f32 v112, 1.0, v112
    v_rcp_f32 v111, v111
    v_rcp_f32 v112, v112
    v_mul_f32 v109, v109, v111
    v_mul_f32 v110, v110, v112
    v_cvt_pk_bf16_f32 v108, v109, v110
    ds_write_b32 v4, v108 offset:30976
    s_mov_b64 exec, -1
    s_waitcnt lgkmcnt(0)
    s_barrier
    s_waitcnt vmcnt(0)
    v_bitop3_b32 v109, v80, v81, v83 bitop3:0x96
    v_xor_b32 v108, s32, v109
    v_bitop3_b32 v108, v82, s31, v108 bitop3:0xbe
    v_bitop3_b32 v109, v16, v17, v19 bitop3:0x96
    v_bitop3_b32 v108, v109, s32, v108 bitop3:0xbe
    v_bitop3_b32 v108, v18, s31, v108 bitop3:0xbe
    v_bitop3_b32 v109, v20, v21, v23 bitop3:0x96
    v_bitop3_b32 v108, v109, s32, v108 bitop3:0xbe
    v_bitop3_b32 v108, v22, s31, v108 bitop3:0xbe
    v_bitop3_b32 v109, v24, v25, v27 bitop3:0x96
    v_bitop3_b32 v108, v109, s32, v108 bitop3:0xbe
    v_bitop3_b32 v108, v26, s31, v108 bitop3:0xbe
    v_bitop3_b32 v109, v28, v29, v31 bitop3:0x96
    v_bitop3_b32 v108, v109, s32, v108 bitop3:0xbe
    v_bitop3_b32 v108, v30, s31, v108 bitop3:0xbe
    v_bitop3_b32 v109, v32, v33, v35 bitop3:0x96
    v_bitop3_b32 v108, v109, s32, v108 bitop3:0xbe
    v_bitop3_b32 v108, v34, s31, v108 bitop3:0xbe
    v_bitop3_b32 v109, v36, v37, v39 bitop3:0x96
    v_bitop3_b32 v108, v109, s32, v108 bitop3:0xbe
    v_bitop3_b32 v108, v38, s31, v108 bitop3:0xbe
    v_bitop3_b32 v109, v40, v41, v43 bitop3:0x96
    v_bitop3_b32 v108, v109, s32, v108 bitop3:0xbe
    v_bitop3_b32 v108, v42, s31, v108 bitop3:0xbe
    v_bitop3_b32 v109, v44, v45, v47 bitop3:0x96
    v_bitop3_b32 v108, v109, s32, v108 bitop3:0xbe
    v_bitop3_b32 v108, v46, s31, v108 bitop3:0xbe
    v_cmp_ne_u32 vcc, 0, v108
    s_cbranch_vccnz L_g2_retry
L_g2_ok:
    v_max_f32_dpp v110, v80, v80 quad_perm:[1,0,3,2] row_mask:0xf bank_mask:0xf
    s_nop 1
    v_max_f32_dpp v110, v110, v110 quad_perm:[2,3,0,1] row_mask:0xf bank_mask:0xf
    s_nop 1
    v_max_f32_dpp v110, v110, v110 row_half_mirror row_mask:0xf bank_mask:0xf
    v_sub_f32 v111, v80, v110
    v_mul_f32 v111, 0x3fb8aa3b, v111
    v_exp_f32 v111, v111
    s_nop 0
    v_mul_f32 v81, v81, v111
    v_readlane_b32 s4, v111, 0
    v_readlane_b32 s5, v111, 1
    v_readlane_b32 s6, v111, 2
    v_readlane_b32 s7, v111, 3
    v_readlane_b32 s8, v111, 4
    v_readlane_b32 s9, v111, 5
    v_readlane_b32 s10, v111, 6
    v_readlane_b32 s11, v111, 7
    v_add_f32_dpp v81, v81, v81 quad_perm:[1,0,3,2] row_mask:0xf bank_mask:0xf
    s_nop 1
    v_add_f32_dpp v81, v81, v81 quad_perm:[2,3,0,1] row_mask:0xf bank_mask:0xf
    s_nop 1
    v_add_f32_dpp v81, v81, v81 row_half_mirror row_mask:0xf bank_mask:0xf
    v_mul_f32 v112, s4, v16
    v_mul_f32 v113, s4, v17
    v_fmac_f32 v112, s5, v20
    v_fmac_f32 v113, s5, v21
    v_fmac_f32 v112, s6, v24
    v_fmac_f32 v113, s6, v25
    v_fmac_f32 v112, s7, v28
    v_fmac_f32 v113, s7, v29
    v_fmac_f32 v112, s8, v32
    v_fmac_f32 v113, s8, v33
    v_fmac_f32 v112, s9, v36
    v_fmac_f32 v113, s9, v37
    v_fmac_f32 v112, s10, v40
    v_fmac_f32 v113, s10, v41
    v_fmac_f32 v112, s11, v44
    v_fmac_f32 v113, s11, v45
    v_rcp_f32 v114, v81
    s_nop 0
    v_mul_f32 v112, v112, v114
    v_mul_f32 v113, v113, v114
    v_cvt_pk_bf16_f32 v112, v112, v113
    ds_write_b32 v4, v112 offset:31104
    s_waitcnt lgkmcnt(0)
    s_barrier
    v_mov_b32 v104, 0
    v_mov_b32 v105, 0
    s_cmp_ge_u32 s34, 27
    s_cbranch_scc1 L_noyf
    ds_read_b64 v[84:85], v3 offset:24576
    ds_read_b64 v[86:87], v3 offset:26112
    ds_read_b64 v[88:89], v3 offset:27648
    ds_read_b64 v[90:91], v3 offset:29184
    s_waitcnt lgkmcnt(0)
    v_add_f32 v104, v84, v86
    v_add_f32 v105, v85, v87
    v_add_f32 v108, v88, v90
    v_add_f32 v109, v89, v91
    v_add_f32 v104, v104, v108
    v_add_f32 v105, v105, v109
L_noyf:
    v_bitop3_b32 v107, v104, v105, s32 bitop3:0x96
    s_mov_b32 s68, -1
    s_mov_b32 s69, 0xff
    s_mov_b64 exec, s[68:69]
    global_store_dwordx4 v6, v[104:107], s[56:57] offset:1024 sc1
    s_mov_b64 exec, -1
    s_cmp_lg_u32 s51, 0
    s_cbranch_scc1 L_b2done
    s_add_u32 s68, s44, 1048576
    s_addc_u32 s69, s45, 0
    global_store_dwordx4 v2, v[136:139], s[68:69] sc1
    s_mov_b64 exec, 1
    global_store_dwordx4 v2, v[140:143], s[68:69] offset:1024 sc1
    s_mov_b64 exec, -1
L_b2done:
    s_barrier
    ds_read_b64 v[84:85], v3 offset:0
    ds_read_b64 v[86:87], v3 offset:1536
    ds_read_b64 v[88:89], v3 offset:3072
    ds_read_b64 v[90:91], v3 offset:4608
    ds_read_b64 v[92:93], v3 offset:6144
    ds_read_b64 v[94:95], v3 offset:7680
    ds_read_b64 v[96:97], v3 offset:9216
    ds_read_b64 v[98:99], v3 offset:10752
    s_waitcnt lgkmcnt(4)
    v_add_f32 v100, v84, v86
    v_add_f32 v101, v85, v87
    v_add_f32 v108, v88, v90
    v_add_f32 v109, v89, v91
    v_add_f32 v100, v100, v108
    v_add_f32 v101, v101, v109
    s_waitcnt lgkmcnt(0)
    v_add_f32 v108, v92, v94
    v_add_f32 v109, v93, v95
    v_add_f32 v110, v96, v98
    v_add_f32 v111, v97, v99
    v_add_f32 v108, v108, v110
    v_add_f32 v109, v109, v111
    v_add_f32 v100, v100, v108
    v_add_f32 v101, v101, v109
    v_bitop3_b32 v103, v100, v101, s32 bitop3:0x96
    s_mov_b32 s68, -1
    s_mov_b32 s69, 0xff
    s_mov_b64 exec, s[68:69]
    global_store_dwordx4 v6, v[100:103], s[56:57] sc1
    s_mov_b64 exec, -1
    s_cmp_ge_u32 s34, 20
    s_cbranch_scc1 L_fin_stamps
    global_load_dwordx4 v[16:19], v2, s[58:59] offset:1024 sc1
    global_load_dwordx4 v[20:23], v2, s[58:59] sc1
    v_mov_b32 v112, s40
    v_mov_b32 v113, s42
    v_mov_b32 v114, s41
    v_mov_b32 v115, s43
    v_cmp_gt_u32 vcc, 32, v1
    s_nop 1
    v_cndmask_b32 v112, v114, v112, vcc
    v_cndmask_b32 v113, v115, v113, vcc
    v_lshrrev_b32 v116, 5, v1
    v_lshlrev_b32 v116, 2, v116
    v_add_u32 v116, s62, v116
    s_sleep 1
    global_load_dwordx4 v[24:27], v2, s[58:59] sc1
    s_sleep 1
    global_load_dwordx4 v[28:31], v2, s[58:59] sc1
    s_sleep 1
    global_load_dwordx4 v[32:35], v2, s[58:59] sc1
    s_waitcnt vmcnt(4)
    v_bitop3_b32 v109, v16, v17, v19 bitop3:0x96
    v_xor_b32 v108, s32, v109
    v_bitop3_b32 v108, v18, s31, v108 bitop3:0xbe
    v_cmp_ne_u32 vcc, 0, v108
    s_cbranch_vccnz L_gf_retry
L_gf_ok:
    v_add_f32_dpp v16, v16, v16 quad_perm:[1,0,3,2] row_mask:0xf bank_mask:0xf
    v_add_f32_dpp v17, v17, v17 quad_perm:[1,0,3,2] row_mask:0xf bank_mask:0xf
    s_nop 0
    v_add_f32_dpp v16, v16, v16 quad_perm:[2,3,0,1] row_mask:0xf bank_mask:0xf
    v_add_f32_dpp v17, v17, v17 quad_perm:[2,3,0,1] row_mask:0xf bank_mask:0xf
    s_nop 0
    v_add_f32_dpp v16, v16, v16 row_half_mirror row_mask:0xf bank_mask:0xf
    v_add_f32_dpp v17, v17, v17 row_half_mirror row_mask:0xf bank_mask:0xf
    s_nop 0
    v_add_f32_dpp v16, v16, v16 row_mirror row_mask:0xf bank_mask:0xf
    v_add_f32_dpp v17, v17, v17 row_mirror row_mask:0xf bank_mask:0xf
    v_mov_b32 v108, v16
    v_mov_b32 v109, v17
    s_nop 0
    v_permlane16_swap_b32 v16, v108
    v_permlane16_swap_b32 v17, v109
    v_add_f32 v16, v16, v108
    v_add_f32 v17, v17, v109
    v_cvt_pk_bf16_f32 v108, v16, v17
    v_lshlrev_b32 v109, 16, v108
    v_and_b32 v110, 0xffff0000, v108
    v_lshlrev_b32 v114, 16, v113
    v_and_b32 v115, 0xffff0000, v113
    v_add_f32 v109, v109, v114
    v_add_f32 v110, v110, v115
    v_cvt_pk_bf16_f32 v108, v109, v110
    v_lshlrev_b32 v109, 16, v108
    v_and_b32 v110, 0xffff0000, v108
    s_mov_b32 s3, 0xbfb8aa3b
    v_mul_f32 v114, s3, v109
    v_mul_f32 v115, s3, v110
    v_exp_f32 v114, v114
    v_exp_f32 v115, v115
    v_add_f32 v114, 1.0, v114
    v_add_f32 v115, 1.0, v115
    v_rcp_f32 v114, v114
    v_rcp_f32 v115, v115
    v_mul_f32 v109, v109, v114
    v_mul_f32 v110, v110, v115
    v_cvt_pk_bf16_f32 v118, v109, v110
    v_lshlrev_b32 v117, 16, v118
    v_and_b32 v118, 0xffff0000, v118
    v_lshlrev_b32 v114, 16, v112
    v_and_b32 v115, 0xffff0000, v112
L_poll:
    s_waitcnt vmcnt(3)
    v_bitop3_b32 v109, v20, v21, v23 bitop3:0x96
    v_xor_b32 v108, s32, v109
    v_bitop3_b32 v108, v22, s31, v108 bitop3:0xbe
    v_cmp_ne_u32 vcc, 0, v108
    s_cbranch_vccz L_got0
    global_load_dwordx4 v[20:23], v2, s[58:59] sc1
    s_waitcnt vmcnt(3)
    v_bitop3_b32 v109, v24, v25, v27 bitop3:0x96
    v_xor_b32 v108, s32, v109
    v_bitop3_b32 v108, v26, s31, v108 bitop3:0xbe
    v_cmp_ne_u32 vcc, 0, v108
    s_cbranch_vccz L_got1
    global_load_dwordx4 v[24:27], v2, s[58:59] sc1
    s_waitcnt vmcnt(3)
    v_bitop3_b32 v109, v28, v29, v31 bitop3:0x96
    v_xor_b32 v108, s32, v109
    v_bitop3_b32 v108, v30, s31, v108 bitop3:0xbe
    v_cmp_ne_u32 vcc, 0, v108
    s_cbranch_vccz L_got2
    global_load_dwordx4 v[28:31], v2, s[58:59] sc1
    s_waitcnt vmcnt(3)
    v_bitop3_b32 v109, v32, v33, v35 bitop3:0x96
    v_xor_b32 v108, s32, v109
    v_bitop3_b32 v108, v34, s31, v108 bitop3:0xbe
    v_cmp_ne_u32 vcc, 0, v108
    s_cbranch_vccz L_got3
    global_load_dwordx4 v[32:35], v2, s[58:59] sc1
    s_add_u32 s46, s46, 1
    s_cmp_lt_u32 s46, 200000
    s_cbranch_scc1 L_poll
L_got3:
    v_mov_b32 v16, v32
    v_mov_b32 v17, v33
    s_branch L_gotall
L_got2:
    v_mov_b32 v16, v28
    v_mov_b32 v17, v29
    s_branch L_gotall
L_got1:
    v_mov_b32 v16, v24
    v_mov_b32 v17, v25
    s_branch L_gotall
L_got0:
    v_mov_b32 v16, v20
    v_mov_b32 v17, v21
L_gotall:
    s_nop 1
    v_add_f32_dpp v16, v16, v16 quad_perm:[1,0,3,2] row_mask:0xf bank_mask:0xf
    v_add_f32_dpp v17, v17, v17 quad_perm:[1,0,3,2] row_mask:0xf bank_mask:0xf
    s_nop 0
    v_add_f32_dpp v16, v16, v16 quad_perm:[2,3,0,1] row_mask:0xf bank_mask:0xf
    v_add_f32_dpp v17, v17, v17 quad_perm:[2,3,0,1] row_mask:0xf bank_mask:0xf
    s_nop 0
    v_add_f32_dpp v16, v16, v16 row_half_mirror row_mask:0xf bank_mask:0xf
    v_add_f32_dpp v17, v17, v17 row_half_mirror row_mask:0xf bank_mask:0xf
    s_nop 0
    v_add_f32_dpp v16, v16, v16 row_mirror row_mask:0xf bank_mask:0xf
    v_add_f32_dpp v17, v17, v17 row_mirror row_mask:0xf bank_mask:0xf
    v_mov_b32 v108, v16
    v_mov_b32 v109, v17
    s_nop 0
    v_permlane16_swap_b32 v16, v108
    v_permlane16_swap_b32 v17, v109
    v_add_f32 v16, v16, v108
    v_add_f32 v17, v17, v109
    v_cvt_pk_bf16_f32 v111, v16, v17
    v_lshlrev_b32 v109, 16, v111
    v_and_b32 v110, 0xffff0000, v111
    v_mul_f32 v109, v109, v117
    v_mul_f32 v110, v110, v118
    v_cvt_pk_bf16_f32 v108, v109, v110
    v_lshlrev_b32 v109, 16, v108
    v_and_b32 v110, 0xffff0000, v108
    v_add_f32 v109, v109, v114
    v_add_f32 v110, v110, v115
    v_cvt_pk_bf16_f32 v108, v109, v110
    s_mov_b32 s68, 1
    s_mov_b32 s69, 1
    s_mov_b64 exec, s[68:69]
    global_store_dword v116, v108, s[24:25]
    s_cmp_lg_u32 s2, 0
    s_cbranch_scc1 L_fin_stamps
    s_mov_b64 exec, 1
    v_mov_b32 v110, 0
    v_mov_b32 v111, s31
    global_store_dword v110, v111, s[28:29] sc1
L_fin_stamps:
L_end:
    s_endpgm
L_p1_retry:
    s_cmp_lt_u32 s3, 1024
    s_cbranch_scc1 L_p1
    s_mov_b32 s12, 0
L_p1_glc:
    s_load_dwordx8 s[4:11], s[48:49], 960 glc
    s_add_u32 s12, s12, 1
    s_waitcnt lgkmcnt(0)
    s_xor_b32 s4, s4, s31
    s_xor_b32 s5, s5, s31
    s_xor_b32 s6, s6, s31
    s_xor_b32 s7, s7, s31
    s_xor_b32 s8, s8, s31
    s_xor_b32 s9, s9, s31
    s_xor_b32 s10, s10, s31
    s_xor_b32 s11, s11, s31
    s_or_b32 s4, s4, s5
    s_or_b32 s6, s6, s7
    s_or_b32 s8, s8, s9
    s_or_b32 s10, s10, s11
    s_or_b32 s4, s4, s6
    s_or_b32 s8, s8, s10
    s_or_b32 s4, s4, s8
    s_cbranch_scc0 L_p1_ok
    s_cmp_lt_u32 s12, 8
    s_cbranch_scc1 L_p1_glc
    s_mov_b32 s50, 1
    s_add_u32 s68, s54, 1048576
    s_addc_u32 s69, s55, 0
    global_store_dwordx4 v2, v[128:131], s[68:69] sc1
    s_add_u32 s52, s52, 1048576
    s_addc_u32 s53, s53, 0
    s_branch L_p1_ok
L_g1_retry:
    s_mov_b32 s3, 0
L_g1_rl:
    global_load_dwordx4 v[16:19], v2, s[52:53] offset:0 sc1
    global_load_dwordx4 v[20:23], v2, s[52:53] offset:2048 sc1
    global_load_dwordx4 v[24:27], v122, s[52:53] offset:0 sc1
    global_load_dwordx4 v[28:31], v122, s[52:53] offset:2048 sc1
    global_load_dwordx4 v[32:35], v123, s[52:53] offset:0 sc1
    global_load_dwordx4 v[36:39], v123, s[52:53] offset:2048 sc1
    global_load_dwordx4 v[40:43], v121, s[52:53] offset:0 sc1
    global_load_dwordx4 v[44:47], v121, s[52:53] offset:2048 sc1
    s_waitcnt vmcnt(0)
    v_bitop3_b32 v109, v16, v17, v19 bitop3:0x96
    v_xor_b32 v108, s32, v109
    v_bitop3_b32 v108, v18, s31, v108 bitop3:0xbe
    v_bitop3_b32 v109, v20, v21, v23 bitop3:0x96
    v_bitop3_b32 v108, v109, s32, v108 bitop3:0xbe
    v_bitop3_b32 v108, v22, s31, v108 bitop3:0xbe
    v_bitop3_b32 v109, v24, v25, v27 bitop3:0x96
    v_bitop3_b32 v108, v109, s32, v108 bitop3:0xbe
    v_bitop3_b32 v108, v26, s31, v108 bitop3:0xbe
    v_bitop3_b32 v109, v28, v29, v31 bitop3:0x96
    v_bitop3_b32 v108, v109, s32, v108 bitop3:0xbe
    v_bitop3_b32 v108, v30, s31, v108 bitop3:0xbe
    v_bitop3_b32 v109, v32, v33, v35 bitop3:0x96
    v_bitop3_b32 v108, v109, s32, v108 bitop3:0xbe
    v_bitop3_b32 v108, v34, s31, v108 bitop3:0xbe
    v_bitop3_b32 v109, v36, v37, v39 bitop3:0x96
    v_bitop3_b32 v108, v109, s32, v108 bitop3:0xbe
    v_bitop3_b32 v108, v38, s31, v108 bitop3:0xbe
    v_bitop3_b32 v109, v40, v41, v43 bitop3:0x96
    v_bitop3_b32 v108, v109, s32, v108 bitop3:0xbe
    v_bitop3_b32 v108, v42, s31, v108 bitop3:0xbe
    v_bitop3_b32 v109, v44, v45, v47 bitop3:0x96
    v_bitop3_b32 v108, v109, s32, v108 bitop3:0xbe
    v_bitop3_b32 v108, v46, s31, v108 bitop3:0xbe
    v_cmp_eq_u32 vcc, 0, v108
    s_cmp_eq_u64 vcc, exec
    s_cbranch_scc1 L_g1_ok
    s_add_u32 s46, s46, 1
    s_add_u32 s3, s3, 1
    s_cmp_lg_u32 s50, 0
    s_cbranch_scc1 L_g1_chk
    s_cmp_lt_u32 s3, 8
    s_cbranch_scc1 L_g1_rl
    s_mov_b32 s50, 1
    s_mov_b64 s[70:71], exec
    s_mov_b64 exec, -1
    s_add_u32 s68, s54, 1048576
    s_addc_u32 s69, s55, 0
    global_store_dwordx4 v2, v[128:131], s[68:69] sc1
    s_add_u32 s68, s54, 1048576
    s_addc_u32 s69, s55, 0
    s_mov_b64 exec, 0xffffffff
    global_store_dwordx4 v2, v[132:135], s[68:69] offset:1024 sc1
    s_mov_b64 exec, -1
    s_mov_b64 exec, s[70:71]
    s_add_u32 s52, s52, 1048576
    s_addc_u32 s53, s53, 0
L_g1_chk:
    s_cmp_lt_u32 s46, 200000
    s_cbranch_scc1 L_g1_rl
    s_branch L_g1_ok
L_p2_retry:
    s_cmp_lt_u32 s3, 2048
    s_cbranch_scc1 L_p2
    s_mov_b32 s12, 0
L_p2_glc:
    s_load_dwordx8 s[4:11], s[48:49], 1984 glc
    s_add_u32 s12, s12, 1
    s_waitcnt lgkmcnt(0)
    s_xor_b32 s4, s4, s31
    s_xor_b32 s5, s5, s31
    s_xor_b32 s6, s6, s31
    s_xor_b32 s7, s7, s31
    s_xor_b32 s8, s8, s31
    s_xor_b32 s9, s9, s31
    s_xor_b32 s10, s10, s31
    s_xor_b32 s11, s11, s31
    s_or_b32 s4, s4, s5
    s_or_b32 s6, s6, s7
    s_or_b32 s8, s8, s9
    s_or_b32 s10, s10, s11
    s_or_b32 s4, s4, s6
    s_or_b32 s8, s8, s10
    s_or_b32 s4, s4, s8
    s_cbranch_scc0 L_p2_ok
    s_cmp_lt_u32 s12, 8
    s_cbranch_scc1 L_p2_glc
    s_mov_b32 s51, 1
    s_add_u32 s68, s44, 1048576
    s_addc_u32 s69, s45, 0
    global_store_dwordx4 v2, v[136:139], s[68:69] sc1
    s_mov_b64 exec, 1
    global_store_dwordx4 v2, v[140:143], s[68:69] offset:1024 sc1
    s_mov_b64 exec, -1
    s_add_u32 s36, s36, 1048576
    s_addc_u32 s37, s37, 0
    s_branch L_p2_ok
L_gh_retry:
    s_mov_b32 s3, 0
L_gh_rl:
    global_load_dwordx4 v[48:51], v2, s[52:53] offset:1024 sc1
    global_load_dwordx4 v[52:55], v2, s[52:53] offset:3072 sc1
    global_load_dwordx4 v[56:59], v122, s[52:53] offset:1024 sc1
    global_load_dwordx4 v[60:63], v122, s[52:53] offset:3072 sc1
    global_load_dwordx4 v[64:67], v123, s[52:53] offset:1024 sc1
    global_load_dwordx4 v[68:71], v123, s[52:53] offset:3072 sc1
    global_load_dwordx4 v[72:75], v121, s[52:53] offset:1024 sc1
    global_load_dwordx4 v[76:79], v121, s[52:53] offset:3072 sc1
    s_waitcnt vmcnt(0)
    v_bitop3_b32 v109, v48, v49, v51 bitop3:0x96
    v_xor_b32 v108, s32, v109
    v_bitop3_b32 v108, v50, s31, v108 bitop3:0xbe
    v_bitop3_b32 v109, v52, v53, v55 bitop3:0x96
    v_bitop3_b32 v108, v109, s32, v108 bitop3:0xbe
    v_bitop3_b32 v108, v54, s31, v108 bitop3:0xbe
    v_bitop3_b32 v109, v56, v57, v59 bitop3:0x96
    v_bitop3_b32 v108, v109, s32, v108 bitop3:0xbe
    v_bitop3_b32 v108, v58, s31, v108 bitop3:0xbe
    v_bitop3_b32 v109, v60, v61, v63 bitop3:0x96
    v_bitop3_b32 v108, v109, s32, v108 bitop3:0xbe
    v_bitop3_b32 v108, v62, s31, v108 bitop3:0xbe
    v_bitop3_b32 v109, v64, v65, v67 bitop3:0x96
    v_bitop3_b32 v108, v109, s32, v108 bitop3:0xbe
    v_bitop3_b32 v108, v66, s31, v108 bitop3:0xbe
    v_bitop3_b32 v109, v68, v69, v71 bitop3:0x96
    v_bitop3_b32 v108, v109, s32, v108 bitop3:0xbe
    v_bitop3_b32 v108, v70, s31, v108 bitop3:0xbe
    v_bitop3_b32 v109, v72, v73, v75 bitop3:0x96
    v_bitop3_b32 v108, v109, s32, v108 bitop3:0xbe
    v_bitop3_b32 v108, v74, s31, v108 bitop3:0xbe
    v_bitop3_b32 v109, v76, v77, v79 bitop3:0x96
    v_bitop3_b32 v108, v109, s32, v108 bitop3:0xbe
    v_bitop3_b32 v108, v78, s31, v108 bitop3:0xbe
    v_cmp_eq_u32 vcc, 0, v108
    s_cmp_eq_u64 vcc, exec
    s_cbranch_scc1 L_gh_ok
    s_add_u32 s46, s46, 1
    s_add_u32 s3, s3, 1
    s_cmp_lg_u32 s50, 0
    s_cbranch_scc1 L_gh_chk
    s_cmp_lt_u32 s3, 8
    s_cbranch_scc1 L_gh_rl
    s_mov_b32 s50, 1
    s_mov_b64 s[70:71], exec
    s_mov_b64 exec, -1
    s_add_u32 s68, s54, 1048576
    s_addc_u32 s69, s55, 0
    global_store_dwordx4 v2, v[128:131], s[68:69] sc1
    s_add_u32 s68, s54, 1048576
    s_addc_u32 s69, s55, 0
    s_mov_b64 exec, 0xffffffff
    global_store_dwordx4 v2, v[132:135], s[68:69] offset:1024 sc1
    s_mov_b64 exec, -1
    s_mov_b64 exec, s[70:71]
    s_add_u32 s52, s52, 1048576
    s_addc_u32 s53, s53, 0
L_gh_chk:
    s_cmp_lt_u32 s46, 200000
    s_cbranch_scc1 L_gh_rl
    s_branch L_gh_ok
L_g2_retry:
    s_mov_b32 s3, 0
L_g2_rl:
    global_load_dwordx4 v[80:83], v5, s[36:37] offset:1024 sc1
    global_load_dwordx4 v[16:19], v2, s[36:37] offset:0 sc1
    global_load_dwordx4 v[20:23], v2, s[36:37] offset:2048 sc1
    global_load_dwordx4 v[24:27], v122, s[36:37] offset:0 sc1
    global_load_dwordx4 v[28:31], v122, s[36:37] offset:2048 sc1
    global_load_dwordx4 v[32:35], v123, s[36:37] offset:0 sc1
    global_load_dwordx4 v[36:39], v123, s[36:37] offset:2048 sc1
    global_load_dwordx4 v[40:43], v121, s[36:37] offset:0 sc1
    global_load_dwordx4 v[44:47], v121, s[36:37] offset:2048 sc1
    s_waitcnt vmcnt(0)
    v_bitop3_b32 v109, v80, v81, v83 bitop3:0x96
    v_xor_b32 v108, s32, v109
    v_bitop3_b32 v108, v82, s31, v108 bitop3:0xbe
    v_bitop3_b32 v109, v16, v17, v19 bitop3:0x96
    v_bitop3_b32 v108, v109, s32, v108 bitop3:0xbe
    v_bitop3_b32 v108, v18, s31, v108 bitop3:0xbe
    v_bitop3_b32 v109, v20, v21, v23 bitop3:0x96
    v_bitop3_b32 v108, v109, s32, v108 bitop3:0xbe
    v_bitop3_b32 v108, v22, s31, v108 bitop3:0xbe
    v_bitop3_b32 v109, v24, v25, v27 bitop3:0x96
    v_bitop3_b32 v108, v109, s32, v108 bitop3:0xbe
    v_bitop3_b32 v108, v26, s31, v108 bitop3:0xbe
    v_bitop3_b32 v109, v28, v29, v31 bitop3:0x96
    v_bitop3_b32 v108, v109, s32, v108 bitop3:0xbe
    v_bitop3_b32 v108, v30, s31, v108 bitop3:0xbe
    v_bitop3_b32 v109, v32, v33, v35 bitop3:0x96
    v_bitop3_b32 v108, v109, s32, v108 bitop3:0xbe
    v_bitop3_b32 v108, v34, s31, v108 bitop3:0xbe
    v_bitop3_b32 v109, v36, v37, v39 bitop3:0x96
    v_bitop3_b32 v108, v109, s32, v108 bitop3:0xbe
    v_bitop3_b32 v108, v38, s31, v108 bitop3:0xbe
    v_bitop3_b32 v109, v40, v41, v43 bitop3:0x96
    v_bitop3_b32 v108, v109, s32, v108 bitop3:0xbe
    v_bitop3_b32 v108, v42, s31, v108 bitop3:0xbe
    v_bitop3_b32 v109, v44, v45, v47 bitop3:0x96
    v_bitop3_b32 v108, v109, s32, v108 bitop3:0xbe
    v_bitop3_b32 v108, v46, s31, v108 bitop3:0xbe
    v_cmp_eq_u32 vcc, 0, v108
    s_cmp_eq_u64 vcc, exec
    s_cbranch_scc1 L_g2_ok
    s_add_u32 s46, s46, 1
    s_add_u32 s3, s3, 1
    s_cmp_lg_u32 s51, 0
    s_cbranch_scc1 L_g2_chk
    s_cmp_lt_u32 s3, 8
    s_cbranch_scc1 L_g2_rl
    s_mov_b32 s51, 1
    s_mov_b64 s[70:71], exec
    s_mov_b64 exec, -1
    s_add_u32 s68, s44, 1048576
    s_addc_u32 s69, s45, 0
    global_store_dwordx4 v2, v[136:139], s[68:69] sc1
    s_mov_b64 exec, 1
    global_store_dwordx4 v2, v[140:143], s[68:69] offset:1024 sc1
    s_mov_b64 exec, -1
    s_mov_b64 exec, s[70:71]
    s_add_u32 s36, s36, 1048576
    s_addc_u32 s37, s37, 0
L_g2_chk:
    s_cmp_lt_u32 s46, 200000
    s_cbranch_scc1 L_g2_rl
    s_branch L_g2_ok
L_gf_retry:
    global_load_dwordx4 v[16:19], v2, s[58:59] offset:1024 sc1
    s_waitcnt vmcnt(0)
    v_bitop3_b32 v109, v16, v17, v19 bitop3:0x96
    v_xor_b32 v108, s32, v109
    v_bitop3_b32 v108, v18, s31, v108 bitop3:0xbe
    v_cmp_eq_u32 vcc, 0, v108
    s_cmp_eq_u64 vcc, exec
    s_cbranch_scc1 L_gf_ok
    s_add_u32 s46, s46, 1
    s_cmp_lt_u32 s46, 200000
    s_cbranch_scc1 L_gf_retry
    s_branch L_gf_ok
L_code_end:
.section .rodata,"a"
.p2align 6
.amdhsa_kernel recurrent_scan__sliding_block_cached__dense_activation_gelu__decode_kernel
  .amdhsa_next_free_vgpr 160
  .amdhsa_next_free_sgpr 102
  .amdhsa_accum_offset 160
  .amdhsa_group_segment_fixed_size 0
  .amdhsa_kernarg_size 104
  .amdhsa_user_sgpr_count 2
  .amdhsa_user_sgpr_kernarg_segment_ptr 1
  .amdhsa_system_sgpr_workgroup_id_x 1
.end_amdhsa_kernel
```
